```python
import torch

def _softmax(x, axis=-1):
    return torch.softmax(x, dim=axis)
def _gelu(x):
    return torch.nn.functional.gelu(x, approximate="tanh")
def _silu(x):
    return torch.nn.functional.silu(x)
def _sigmoid(x):
    return torch.sigmoid(x)
def _layernorm(x, axis=-1, eps=1e-5):
    m = x.mean(dim=axis, keepdim=True)
    v = x.var(dim=axis, keepdim=True, unbiased=False)
    return (x - m) / torch.sqrt(v + eps)
def _scatter_add(tgt, idx, src, axis=0):
    return tgt.clone().index_add_(axis, idx, src)
def _segment_sum(src, seg, n):
    out = torch.zeros((n,) + src.shape[1:], dtype=src.dtype)
    return out.index_add_(0, seg, src)
def _pad(x, pw):
    flat = tuple(v for pair in reversed(pw) for v in pair)
    return torch.nn.functional.pad(x, flat)

kernel_name = 'sequential_preLN__sliding_block_cached__dense_activation_silu__decode'

def setup_inputs():

    _w = (lambda a: (lambda t: t.to(torch.bfloat16) if t.is_floating_point() else t)(torch.as_tensor(a)))
    def _A_setup():
        B, Sq, D = 4, 1, 512
        Hq, Hkv, Sk, Dh = 32, 8, 16384, 128
        assert Hq % Hkv == 0, (Hq, Hkv)
        return {
            "x": _w((lambda *s: torch.randn(*s, dtype=torch.bfloat16) * 0.05)(B, Sq, D)),
            "k_cache": _w((lambda *s: torch.randn(*s, dtype=torch.bfloat16) * 3.2)(B, Hkv, Sk, Dh)),
            "v_cache": _w((lambda *s: torch.randn(*s, dtype=torch.bfloat16) * 0.8)(B, Hkv, Sk, Dh)),
            "wq": _w((lambda *s: torch.randn(*s, dtype=torch.bfloat16) * 3.2)(D, Hq * Dh) * (D ** -0.5)),
            "wo": _w((lambda *s: torch.randn(*s, dtype=torch.bfloat16) * 0.8)(Hq * Dh, D) * ((Hq * Dh) ** -0.5)),
        }
    _A_in = _A_setup()

    def _B_setup():
        B, S, D, F = 4, 1, 512, 1792
        return {
            "x": _w((lambda *s: torch.randn(*s, dtype=torch.bfloat16) * 0.05)(B, S, D)),
            "w1": _w((lambda *s: torch.randn(*s, dtype=torch.bfloat16) * 3.2)(D, F) * (D ** -0.5)),
            "w2": _w((lambda *s: torch.randn(*s, dtype=torch.bfloat16) * 0.8)(F, D) * (F ** -0.5)),
        }
    _B_in = _B_setup()

    return {
        "A_x": _A_in["x"],
        "A_k_cache": _A_in["k_cache"],
        "A_v_cache": _A_in["v_cache"],
        "A_wq": _A_in["wq"],
        "A_wo": _A_in["wo"],
        "B_x": _B_in["x"],
        "B_w1": _B_in["w1"],
        "B_w2": _B_in["w2"],
    }

def reference(A_x, A_k_cache, A_v_cache, A_wq, A_wo, B_x, B_w1, B_w2):
    def _A_ref(x, k_cache, v_cache, wq, wo):
        B, Sq, D = x.shape
        Hq, Dh = 32, 128
        Hkv, Sk = k_cache.shape[1], k_cache.shape[2]
        W = min(4096, max(256, Sk // 4))
        rep = Hq // Hkv
        q = (lambda x, *d: x.permute(*d))((x @ wq).reshape(B, Sq, Hq, Dh), 0, 2, 1, 3)
        k = (lambda x, n, axis: torch.repeat_interleave(x, n, dim=axis))(k_cache[:, :, Sk - W:, :], rep, axis=1)
        v = (lambda x, n, axis: torch.repeat_interleave(x, n, dim=axis))(v_cache[:, :, Sk - W:, :], rep, axis=1)
        scores = torch.einsum("bhqd,bhkd->bhqk", q, k) * (Dh ** -0.5)
        p = _softmax(scores, axis=-1)
        o = torch.einsum("bhqk,bhkd->bhqd", p, v)
        return (lambda x, *d: x.permute(*d))(o, 0, 2, 1, 3).reshape(B, Sq, Hq * Dh) @ wo

    def _B_ref(x, w1, w2):
        h = torch.einsum("bsd,df->bsf", x, w1)
        h = _silu(h)
        out = torch.einsum("bsf,fd->bsd", h, w2)
        return out

    x = A_x
    h = x + _A_ref(_layernorm(x, axis=-1), A_k_cache, A_v_cache, A_wq, A_wo)
    h2 = h + _B_ref(_layernorm(h, axis=-1), B_w1, B_w2)
    return h2
```

```asm
; @launch grid=(256,1,1) block=(768,1,1) lds=138048
.amdgcn_target "amdgcn-amd-amdhsa--gfx950"
.text
.globl sequential_preLN__sliding_block_cached__dense_activation_silu__decode_kernel
.p2align 8
.type sequential_preLN__sliding_block_cached__dense_activation_silu__decode_kernel,@function
sequential_preLN__sliding_block_cached__dense_activation_silu__decode_kernel:
    s_cmp_ge_u32 s2, 256
    s_cbranch_scc1 L_end
    s_getpc_b64 s[62:63]
    v_min_u32 v158, (L_last-sequential_preLN__sliding_block_cached__dense_activation_silu__decode_kernel)/128-1, v0
    v_lshlrev_b32 v158, 7, v158
    global_load_dword v159, v158, s[62:63]
    v_mov_b32 v155, 138016
    v_mov_b32 v156, 0
    v_mov_b32 v157, 0
    ds_write_b64 v155, v[156:157]
    v_lshrrev_b32 v1, 6, v0
    v_and_b32 v2, 63, v0
    v_readfirstlane_b32 s3, v1
    s_waitcnt lgkmcnt(0)
    s_load_dwordx16 s[4:19], s[0:1], 0
    s_load_dwordx2 s[20:21], s[0:1], 64
    s_load_dwordx2 s[22:23], s[0:1], 80
    s_and_b32 s24, s2, 7
    s_lshr_b32 s25, s2, 3
    s_and_b32 s26, s25, 3
    s_lshr_b32 s27, s25, 2
    v_lshrrev_b32 v3, 4, v2
    v_and_b32 v4, 3, v2
    v_bfe_u32 v5, v2, 2, 2
    v_lshlrev_b32 v6, 4, v2
    s_sub_u32 s3, s3, 4
    s_barrier
    s_cbranch_scc1 L_tail
    s_lshl_b32 s36, s26, 3
    s_add_u32 s36, s36, s24
    s_lshl_b32 s36, s36, 22
    s_lshl_b32 s37, s27, 3
    s_add_u32 s37, s37, s3
    s_lshl_b32 s37, s37, 12
    s_add_u32 s36, s36, s37
    s_add_u32 s36, s36, 0x300000
    v_lshlrev_b32 v7, 8, v5
    v_lshl_add_u32 v7, v3, 6, v7
    v_lshl_add_u32 v7, v4, 4, v7
    s_mov_b32 s30, 0x8000000
    s_mov_b32 s31, 0x20000
    s_lshl_b32 s40, s26, 3
    s_add_u32 s40, s40, s3
    s_lshl_b32 s40, s40, 7
    s_add_u32 s40, s40, s24
    s_lshl_b32 s40, s40, 2
    s_add_u32 s40, s40, s27
    s_lshl_b32 s41, s24, 2
    s_add_u32 s41, s41, s27
    s_lshl_b32 s41, s41, 3
    s_add_u32 s41, s41, s3
    s_lshl_b32 s41, s41, 6
    s_add_u32 s41, s41, s26
    s_sub_u32 s41, s41, 0x800
    s_cmp_lt_u32 s25, 16
    s_cselect_b32 s40, s40, s41
    s_movk_i32 s41, 0x300
    s_cselect_b32 s43, 0x1f00, s41
    s_lshl_b32 s40, s40, 8
    v_lshlrev_b32 v13, 5, v3
    v_xor_b32 v12, v6, v13
    v_mad_u32_u24 v12, v3, s43, v12
    v_xor_b32 v13, 128, v12
    s_lshl_b32 s43, s43, 2
    s_lshl_b32 s42, s3, 14
    s_and_b32 s41, s3, 3
    s_lshl_b32 s41, s41, 10
    v_add_u32 v14, s41, v6
    s_add_u32 m0, s41, 131072
    s_mov_b32 s34, 0x400000
    s_mov_b32 s35, s31
    s_lshl_b32 s44, s3, 2
    s_or_b32 s44, s44, s25
    s_cmp_lt_u32 s44, 16
    s_cselect_b64 exec, -1, 0
    s_cmp_lt_u32 s25, 16
    s_waitcnt lgkmcnt(0)
    global_load_lds_dwordx4 v14, s[4:5]
    s_mov_b64 exec, -1
    s_cselect_b32 s32, s10, s12
    s_cselect_b32 s33, s11, s13
    s_add_u32 m0, s42, 12288
    s_and_b32 s33, s33, 0xffff
    buffer_load_dwordx4 v12, s[32:35], s40 offen offset:0 nt lds
    s_add_u32 s40, s40, s43
    buffer_load_dwordx4 v12, s[32:35], s40 offen offset:1024 nt lds
    s_add_u32 s40, s40, s43
    buffer_load_dwordx4 v13, s[32:35], s40 offen offset:2048 nt lds
    s_add_u32 s40, s40, s43
    buffer_load_dwordx4 v13, s[32:35], s40 offen offset:3072 nt lds
    s_mov_b32 s28, s6
    s_and_b32 s29, s7, 0xffff
    s_waitcnt vmcnt(4)
    buffer_load_dwordx4 v[16:19], v7, s[28:31], s36 offen offset:0 nt
    s_add_u32 s37, s36, 0x40000
    s_add_u32 s38, s36, 0x80000
    s_add_u32 s39, s36, 0xc0000
    s_waitcnt vmcnt(4)
    buffer_load_dwordx4 v[20:23], v7, s[28:31], s36 offen offset:1024 nt
    s_waitcnt vmcnt(4)
    buffer_load_dwordx4 v[24:27], v7, s[28:31], s36 offen offset:2048 nt
    s_waitcnt vmcnt(4)
    buffer_load_dwordx4 v[28:31], v7, s[28:31], s36 offen offset:3072 nt
    s_waitcnt vmcnt(4)
    v_mov_b32 v156, 1
    ds_add_u32 v155, v156
    buffer_load_dwordx4 v[32:35], v7, s[28:31], s37 offen offset:0 nt
    s_load_dwordx2 s[56:57], s[22:23], 0
    s_mov_b32 s32, s8
    s_and_b32 s33, s9, 0xffff
    s_mov_b32 s34, 0x8000000
    s_mov_b32 s35, 0x20000
    s_mov_b32 s48, s22
    s_and_b32 s49, s23, 0xffff
    s_mov_b32 s50, 0xc00000
    s_mov_b32 s51, 0x20000
    v_and_b32 v8, 1, v3
    v_lshlrev_b32 v8, 7, v8
    v_xor_b32 v12, v6, v8
    v_xor_b32 v13, 32, v12
    v_xor_b32 v14, 64, v12
    v_xor_b32 v15, 96, v12
    v_mul_u32_u24 v8, 272, v4
    v_lshl_add_u32 v8, v3, 6, v8
    v_lshl_add_u32 v8, v5, 4, v8
    v_add_u32 v8, 135296, v8
    s_lshl_b32 s40, s3, 2
    s_add_u32 s40, s40, 136384
    v_lshlrev_b32 v9, 5, v4
    v_add_u32 v10, s40, v9
    v_add_u32 v9, 136384, v9
    v_mul_u32_u24 v11, 1056, v4
    v_lshl_add_u32 v11, v3, 4, v11
    v_add_u32 v11, 131072, v11
    s_lshr_b32 s40, s3, 1
    s_lshl_b32 s40, s40, 6
    s_and_b32 s41, s3, 1
    s_lshl_b32 s41, s41, 3
    s_add_u32 s40, s40, s41
    v_add_u32 v84, s40, v11
    v_lshl_add_u32 v84, v5, 1, v84
    v_and_b32 v86, 1, v3
    v_lshl_add_u32 v86, v86, 2, v5
    v_lshlrev_b32 v86, 1, v86
    v_lshrrev_b32 v85, 1, v4
    s_lshl_b32 s40, s3, 1
    v_add_u32 v85, s40, v85
    v_xor_b32 v85, v85, v86
    v_lshlrev_b32 v85, 4, v85
    v_and_b32 v86, 1, v4
    v_lshl_add_u32 v85, v86, 3, v85
    v_lshl_add_u32 v85, v5, 10, v85
    v_lshl_add_u32 v85, v3, 8, v85
    v_add_u32 v86, 0x10000, v85
    v_lshlrev_b32 v87, 15, v4
    v_lshl_add_u32 v87, v3, 5, v87
    v_and_b32 v88, 1, v5
    v_lshl_add_u32 v87, v88, 4, v87
    s_lshl_b32 s40, s24, 3
    s_lshr_b32 s41, s3, 2
    s_add_u32 s40, s40, s41
    s_lshl_b32 s40, s40, 5
    s_lshl_b32 s41, s26, 3
    s_add_u32 s40, s40, s41
    s_add_u32 s40, s40, s27
    s_lshl_b32 s40, s40, 2
    s_and_b32 s41, s3, 3
    s_add_u32 s40, s40, s41
    s_lshl_b32 s40, s40, 7
    s_add_u32 s40, s40, 1572864
    s_mov_b32 s43, 0x3db504f3
    s_mov_b32 s44, 0x3fb8aa3b
    v_mov_b32 v88, 137984
    s_waitcnt vmcnt(4)
    buffer_load_dwordx4 v[36:39], v7, s[28:31], s37 offen offset:1024 nt
    s_waitcnt vmcnt(4)
    buffer_load_dwordx4 v[40:43], v7, s[28:31], s37 offen offset:2048 nt
    s_waitcnt vmcnt(4)
    buffer_load_dwordx4 v[44:47], v7, s[28:31], s37 offen offset:3072 nt
    s_waitcnt vmcnt(4)
    buffer_load_dwordx4 v[48:51], v7, s[28:31], s38 offen offset:0 nt
    s_waitcnt vmcnt(4)
    buffer_load_dwordx4 v[52:55], v7, s[28:31], s38 offen offset:1024 nt
    s_waitcnt vmcnt(4)
    buffer_load_dwordx4 v[56:59], v7, s[28:31], s38 offen offset:2048 nt
    s_waitcnt vmcnt(4)
    s_cmp_eq_u32 s3, 7
    s_cbranch_scc0 L_ng
    ds_write_b32 v155, v156 offset:4
L_ng:
    buffer_load_dwordx4 v[60:63], v7, s[28:31], s38 offen offset:3072 nt
    s_waitcnt vmcnt(4)
    buffer_load_dwordx4 v[64:67], v7, s[28:31], s39 offen offset:0 nt
    s_waitcnt lgkmcnt(0)
    s_add_u32 s56, s56, 0x9e3779b9
    s_add_u32 s57, s57, 0x7f4a7c15
    v_mov_b32 v94, s56
    v_mov_b32 v95, s57
    v_mov_b32 v110, s56
    v_mov_b32 v111, s57
    s_mov_b32 s60, s16
    s_and_b32 s61, s17, 0xffff
    s_mov_b32 s62, 0x1c0000
    s_mov_b32 s63, 0x20000
    s_mov_b32 s52, s18
    s_and_b32 s53, s19, 0xffff
    s_mov_b32 s54, 0x1c0000
    s_mov_b32 s55, 0x20000
    s_cmp_lt_u32 s25, 16
    s_cbranch_scc0 L_sh
    s_mul_i32 s99, s24, 14
    s_add_u32 s99, s99, s25
    v_lshrrev_b32 v128, 1, v2
    v_mul_u32_u24 v128, 3584, v128
    v_and_b32 v129, 1, v2
    v_lshl_add_u32 v128, v129, 4, v128
    v_and_b32 v129, 7, v2
    v_lshlrev_b32 v130, 1, v3
    v_xor_b32 v129, v129, v130
    v_lshlrev_b32 v129, 4, v129
    v_lshrrev_b32 v130, 3, v2
    v_lshl_add_u32 v129, v130, 10, v129
    s_mul_i32 s46, s3, 229376
    s_lshl_b32 s47, s99, 5
    s_add_u32 s46, s46, s47
    s_lshl_b32 s47, s99, 14
    s_lshl_b32 s96, s3, 7
    s_add_u32 s47, s47, s96
    s_lshl_b32 s96, s3, 11
    v_and_b32 v130, 15, v2
    v_lshlrev_b32 v130, 3, v130
    v_lshl_add_u32 v130, v3, 7, v130
    v_add_u32 v130, s96, v130
    v_lshl_add_u32 v131, v3, 2, v5
    v_bfe_u32 v132, v131, 1, 2
    v_lshlrev_b32 v132, 5, v132
    v_lshl_add_u32 v131, v131, 7, v132
    v_lshl_add_u32 v131, v4, 3, v131
    s_add_u32 s97, s96, 16384
    v_add_u32 v131, s97, v131
    v_xor_b32 v132, 32, v131
    v_xor_b32 v133, 64, v131
    v_xor_b32 v134, 96, v131
    v_lshlrev_b32 v135, 4, v4
    v_lshl_add_u32 v135, v5, 9, v135
    v_lshl_add_u32 v135, v3, 7, v135
    s_lshl_b32 s4, s24, 2
    s_lshr_b32 s97, s24, 2
    s_xor_b32 s97, s97, 1
    s_add_u32 s4, s4, s97
    s_lshr_b32 s97, s3, 2
    s_lshl_b32 s97, s97, 1
    s_add_u32 s4, s4, s97
    s_lshl_b32 s4, s4, 2
    s_and_b32 s97, s3, 3
    s_add_u32 s4, s4, s97
    s_lshl_b32 s4, s4, 11
    s_add_u32 s4, s4, 4194304
    v_lshlrev_b32 v136, 6, v4
    v_add_u32 v136, 137728, v136
    s_lshl_b32 s97, s3, 3
    v_lshl_add_u32 v137, v3, 2, v136
    v_add_u32 v137, s97, v137
    v_lshl_add_u32 v136, v5, 4, v136
    v_lshlrev_b32 v138, 6, v3
    v_lshl_add_u32 v138, v4, 4, v138
    v_add_u32 v138, 32768, v138
    v_lshl_add_u32 v139, v5, 9, v138
    s_lshl_b32 s97, s3, 8
    v_add_u32 v138, s97, v138
    v_lshrrev_b32 v141, 1, v5
    v_lshl_add_u32 v141, v141, 2, v3
    v_lshlrev_b32 v140, 14, v141
    v_lshl_add_u32 v140, v4, 4, v140
    v_and_b32 v141, 1, v5
    v_lshl_add_u32 v140, v141, 6, v140
    s_lshl_b32 s5, s3, 18
    s_cmp_ge_u32 s99, 56
    s_cselect_b32 s97, 1024, 0
    s_add_u32 s5, s5, s97
    s_lshl_b32 s97, s99, 7
    s_add_u32 s5, s5, s97
    s_add_u32 s5, s5, 8388608
    s_add_u32 s6, s5, 131072
    s_lshl_b32 s7, s24, 4
    s_add_u32 s7, s7, s25
    s_lshl_b32 s7, s7, 4
    s_add_u32 s7, s7, 32768
    s_cmp_eq_u32 s3, 0
    s_cselect_b32 s8, 1, 0
    s_mov_b32 s9, 0
    s_mov_b32 s59, 0x3f803f80
    s_branch L_sd
L_sh:
    v_and_b32 v130, 1, v3
    v_lshl_add_u32 v130, v130, 2, v5
    v_lshlrev_b32 v130, 1, v130
    v_lshrrev_b32 v131, 1, v4
    s_mul_i32 s58, s3, 2
    v_add_u32 v131, s58, v131
    v_xor_b32 v130, v130, v131
    v_lshlrev_b32 v128, 4, v130
    v_and_b32 v131, 1, v4
    v_lshl_add_u32 v128, v131, 3, v128
    v_and_b32 v130, 1, v3
    v_lshl_add_u32 v130, v130, 3, v5
    v_lshl_add_u32 v128, v130, 8, v128
    v_lshrrev_b32 v130, 1, v3
    v_lshl_add_u32 v128, v130, 14, v128
    v_add_u32 v129, 0x10000, v128
    s_lshl_b32 s99, s24, 2
    s_add_u32 s99, s99, s27
    s_sub_u32 s99, s99, 4
    s_lshl_b32 s4, s99, 1
    s_and_b32 s97, s3, 1
    s_add_u32 s4, s4, s97
    s_lshl_b32 s4, s4, 2
    s_lshr_b32 s96, s3, 1
    s_add_u32 s4, s4, s96
    s_lshl_b32 s4, s4, 12
    s_add_u32 s4, s4, 1572864
    s_lshl_b32 s5, s99, 2
    s_add_u32 s5, s5, s96
    s_lshl_b32 s5, s5, 7
    s_add_u32 s5, s5, 2621440
    s_lshl_b32 s6, s26, 3
    s_add_u32 s6, s6, s3
    s_lshl_b32 s6, s6, 1
    s_lshr_b32 s7, s24, 2
    s_add_u32 s6, s6, s7
    s_lshl_b32 s6, s6, 6
    s_and_b32 s7, s99, 15
    s_add_u32 s6, s6, s7
    s_lshl_b32 s6, s6, 7
    s_add_u32 s6, s6, 3145728
    v_lshrrev_b32 v134, 3, v2
    v_and_b32 v135, 7, v2
    v_lshlrev_b32 v130, 9, v134
    v_lshl_add_u32 v130, v135, 4, v130
    v_lshlrev_b32 v131, 4, v134
    v_lshl_add_u32 v132, v3, 3, v135
    s_mul_i32 s96, s96, 272
    s_lshl_b32 s97, s97, 7
    s_add_u32 s96, s96, s97
    s_add_u32 s96, s96, 136640
    v_lshl_add_u32 v132, v132, 2, s96
    v_mul_u32_u24 v133, 272, v4
    v_lshl_add_u32 v133, v3, 4, v133
    v_add_u32 v133, 136640, v133
    v_lshlrev_b32 v135, 9, v135
    v_lshlrev_b32 v140, 11, v3
    v_lshl_add_u32 v140, v4, 4, v140
    v_and_b32 v134, 1, v5
    v_lshl_add_u32 v140, v134, 6, v140
    s_lshr_b32 s7, s24, 2
    s_lshl_b32 s7, s7, 6
    s_and_b32 s97, s24, 3
    s_add_u32 s7, s7, s97
    s_lshl_b32 s7, s7, 7
    s_add_u32 s7, s7, 16384
    s_lshl_b32 s97, s25, 3
    s_add_u32 s97, s97, s3
    s_cmp_eq_u32 s97, 248
    s_cselect_b32 s8, 0xff, 0
    s_mov_b32 s9, 0
    s_mov_b32 s58, 400000
Lw_1:
    ds_read_b32 v134, v155 offset:0
    s_waitcnt lgkmcnt(0)
    v_cmp_ne_u32 vcc, 0x200, v134
    s_cbranch_vccz Lx_2
    s_sleep 1
    s_sub_u32 s58, s58, 1
    s_cbranch_scc0 Lw_1
Lx_2:
    ds_read_b64_tr_b16 v[112:113], v128 offset:12288
    ds_read_b64_tr_b16 v[114:115], v128 offset:13312
    ds_read_b64_tr_b16 v[116:117], v128 offset:45056
    ds_read_b64_tr_b16 v[118:119], v128 offset:46080
    ds_read_b64_tr_b16 v[120:121], v129 offset:12288
    ds_read_b64_tr_b16 v[122:123], v129 offset:13312
    ds_read_b64_tr_b16 v[124:125], v129 offset:45056
    ds_read_b64_tr_b16 v[126:127], v129 offset:46080
    s_waitcnt lgkmcnt(0)
L_sd:
    s_waitcnt vmcnt(4)
    buffer_load_dwordx4 v[68:71], v7, s[28:31], s39 offen offset:1024 nt
    s_waitcnt vmcnt(4)
    buffer_load_dwordx4 v[72:75], v7, s[28:31], s39 offen offset:2048 nt
    s_waitcnt vmcnt(4)
    buffer_load_dwordx4 v[76:79], v7, s[28:31], s39 offen offset:3072 nt
    s_waitcnt vmcnt(4)
    s_add_u32 m0, s42, 0
    s_nop 0
    buffer_load_dwordx4 v12, s[32:35], s36 offen offset:0 nt lds
    s_waitcnt vmcnt(4)
    buffer_load_dwordx4 v13, s[32:35], s36 offen offset:1024 nt lds
    s_waitcnt vmcnt(4)
    buffer_load_dwordx4 v14, s[32:35], s36 offen offset:2048 nt lds
    s_waitcnt vmcnt(4)
    buffer_load_dwordx4 v15, s[32:35], s36 offen offset:3072 nt lds
    s_waitcnt vmcnt(4)
    s_add_u32 m0, s42, 4096
    s_nop 0
    buffer_load_dwordx4 v12, s[32:35], s37 offen offset:0 nt lds
    s_waitcnt vmcnt(4)
    buffer_load_dwordx4 v13, s[32:35], s37 offen offset:1024 nt lds
    s_waitcnt vmcnt(4)
    buffer_load_dwordx4 v14, s[32:35], s37 offen offset:2048 nt lds
    s_waitcnt vmcnt(4)
    buffer_load_dwordx4 v15, s[32:35], s37 offen offset:3072 nt lds
    s_waitcnt vmcnt(4)
    s_add_u32 m0, s42, 8192
    s_nop 0
    buffer_load_dwordx4 v12, s[32:35], s38 offen offset:0 nt lds
    s_waitcnt vmcnt(4)
    buffer_load_dwordx4 v13, s[32:35], s38 offen offset:1024 nt lds
    s_barrier
    ds_read_b128 v[96:99], v8
    ds_read_b32 v88, v88
    s_waitcnt lgkmcnt(0)
    v_readfirstlane_b32 s45, v88
    v_mfma_f32_16x16x32_bf16 v[80:83], v[16:19], v[96:99], 0
    v_mfma_f32_16x16x32_bf16 v[16:19], v[32:35], v[96:99], 0
    v_mfma_f32_16x16x32_bf16 v[32:35], v[48:51], v[96:99], 0
    v_mfma_f32_16x16x32_bf16 v[48:51], v[64:67], v[96:99], 0
    v_mfma_f32_16x16x32_bf16 v[64:67], v[20:23], v[96:99], 0
    v_mfma_f32_16x16x32_bf16 v[20:23], v[36:39], v[96:99], 0
    v_mfma_f32_16x16x32_bf16 v[36:39], v[52:55], v[96:99], 0
    v_mfma_f32_16x16x32_bf16 v[52:55], v[68:71], v[96:99], 0
    s_waitcnt vmcnt(4)
    buffer_load_dwordx4 v14, s[32:35], s38 offen offset:2048 nt lds
    v_add_f32_dpp v104, v81, v80 row_shl:4 row_mask:0xf bank_mask:0x1
    v_add_f32_dpp v105, v17, v16 row_shl:4 row_mask:0xf bank_mask:0x1
    v_add_f32_dpp v106, v33, v32 row_shl:4 row_mask:0xf bank_mask:0x1
    v_add_f32_dpp v107, v49, v48 row_shl:4 row_mask:0xf bank_mask:0x1
    v_add_f32_dpp v104, v82, v104 row_shl:8 row_mask:0xf bank_mask:0x1
    v_add_f32_dpp v105, v18, v105 row_shl:8 row_mask:0xf bank_mask:0x1
    v_add_f32_dpp v106, v34, v106 row_shl:8 row_mask:0xf bank_mask:0x1
    v_add_f32_dpp v107, v50, v107 row_shl:8 row_mask:0xf bank_mask:0x1
    v_add_f32_dpp v104, v83, v104 row_shl:12 row_mask:0xf bank_mask:0x1
    v_add_f32_dpp v105, v19, v105 row_shl:12 row_mask:0xf bank_mask:0x1
    v_add_f32_dpp v106, v35, v106 row_shl:12 row_mask:0xf bank_mask:0x1
    v_add_f32_dpp v107, v51, v107 row_shl:12 row_mask:0xf bank_mask:0x1
    v_mfma_f32_16x16x32_bf16 v[68:71], v[24:27], v[96:99], 0
    v_mfma_f32_16x16x32_bf16 v[24:27], v[40:43], v[96:99], 0
    v_mfma_f32_16x16x32_bf16 v[40:43], v[56:59], v[96:99], 0
    v_mfma_f32_16x16x32_bf16 v[56:59], v[72:75], v[96:99], 0
    v_add_f32_dpp v104, v64, v65 row_shr:4 row_mask:0xf bank_mask:0x2
    v_add_f32_dpp v105, v20, v21 row_shr:4 row_mask:0xf bank_mask:0x2
    v_add_f32_dpp v106, v36, v37 row_shr:4 row_mask:0xf bank_mask:0x2
    v_add_f32_dpp v107, v52, v53 row_shr:4 row_mask:0xf bank_mask:0x2
    v_add_f32_dpp v104, v66, v104 row_shl:4 row_mask:0xf bank_mask:0x2
    v_add_f32_dpp v105, v22, v105 row_shl:4 row_mask:0xf bank_mask:0x2
    v_add_f32_dpp v106, v38, v106 row_shl:4 row_mask:0xf bank_mask:0x2
    v_add_f32_dpp v107, v54, v107 row_shl:4 row_mask:0xf bank_mask:0x2
    v_add_f32_dpp v104, v67, v104 row_shl:8 row_mask:0xf bank_mask:0x2
    v_add_f32_dpp v105, v23, v105 row_shl:8 row_mask:0xf bank_mask:0x2
    v_add_f32_dpp v106, v39, v106 row_shl:8 row_mask:0xf bank_mask:0x2
    v_add_f32_dpp v107, v55, v107 row_shl:8 row_mask:0xf bank_mask:0x2
    s_waitcnt vmcnt(4)
    buffer_load_dwordx4 v15, s[32:35], s38 offen offset:3072 nt lds
    v_mfma_f32_16x16x32_bf16 v[72:75], v[28:31], v[96:99], 0
    v_mfma_f32_16x16x32_bf16 v[28:31], v[44:47], v[96:99], 0
    v_mfma_f32_16x16x32_bf16 v[44:47], v[60:63], v[96:99], 0
    v_mfma_f32_16x16x32_bf16 v[60:63], v[76:79], v[96:99], 0
    v_add_f32_dpp v104, v68, v70 row_shr:8 row_mask:0xf bank_mask:0x4
    v_add_f32_dpp v105, v24, v26 row_shr:8 row_mask:0xf bank_mask:0x4
    v_add_f32_dpp v106, v40, v42 row_shr:8 row_mask:0xf bank_mask:0x4
    v_add_f32_dpp v107, v56, v58 row_shr:8 row_mask:0xf bank_mask:0x4
    v_add_f32_dpp v104, v69, v104 row_shr:4 row_mask:0xf bank_mask:0x4
    v_add_f32_dpp v105, v25, v105 row_shr:4 row_mask:0xf bank_mask:0x4
    v_add_f32_dpp v106, v41, v106 row_shr:4 row_mask:0xf bank_mask:0x4
    v_add_f32_dpp v107, v57, v107 row_shr:4 row_mask:0xf bank_mask:0x4
    v_add_f32_dpp v104, v71, v104 row_shl:4 row_mask:0xf bank_mask:0x4
    v_add_f32_dpp v105, v27, v105 row_shl:4 row_mask:0xf bank_mask:0x4
    v_add_f32_dpp v106, v43, v106 row_shl:4 row_mask:0xf bank_mask:0x4
    v_add_f32_dpp v107, v59, v107 row_shl:4 row_mask:0xf bank_mask:0x4
    s_waitcnt vmcnt(4)
    s_add_u32 m0, s42, 12288
    s_nop 0
    buffer_load_dwordx4 v12, s[32:35], s39 offen offset:0 nt lds
    v_add_f32_dpp v104, v72, v75 row_shr:12 row_mask:0xf bank_mask:0x8
    v_add_f32_dpp v105, v28, v31 row_shr:12 row_mask:0xf bank_mask:0x8
    v_add_f32_dpp v106, v44, v47 row_shr:12 row_mask:0xf bank_mask:0x8
    v_add_f32_dpp v107, v60, v63 row_shr:12 row_mask:0xf bank_mask:0x8
    v_add_f32_dpp v104, v73, v104 row_shr:8 row_mask:0xf bank_mask:0x8
    v_add_f32_dpp v105, v29, v105 row_shr:8 row_mask:0xf bank_mask:0x8
    v_add_f32_dpp v106, v45, v106 row_shr:8 row_mask:0xf bank_mask:0x8
    v_add_f32_dpp v107, v61, v107 row_shr:8 row_mask:0xf bank_mask:0x8
    v_add_f32_dpp v104, v74, v104 row_shr:4 row_mask:0xf bank_mask:0x8
    v_add_f32_dpp v105, v30, v105 row_shr:4 row_mask:0xf bank_mask:0x8
    v_add_f32_dpp v106, v46, v106 row_shr:4 row_mask:0xf bank_mask:0x8
    v_add_f32_dpp v107, v62, v107 row_shr:4 row_mask:0xf bank_mask:0x8
    v_cvt_pk_bf16_f32 v100, v104, v105
    v_cvt_pk_bf16_f32 v101, v106, v107
    v_lshlrev_b32 v104, 16, v100
    v_and_b32 v105, 0xffff0000, v100
    v_lshlrev_b32 v106, 16, v101
    v_and_b32 v107, 0xffff0000, v101
    v_mul_f32 v104, s43, v104
    v_mul_f32 v105, s43, v105
    v_mul_f32 v106, s43, v106
    v_mul_f32 v107, s43, v107
    v_cvt_pk_bf16_f32 v100, v104, v105
    v_cvt_pk_bf16_f32 v101, v106, v107
    v_lshlrev_b32 v104, 16, v100
    v_and_b32 v105, 0xffff0000, v100
    v_lshlrev_b32 v106, 16, v101
    v_and_b32 v107, 0xffff0000, v101
    v_max3_f32 v100, v104, v105, v106
    v_max_f32 v100, v100, v107
    s_nop 1
    v_max_f32_dpp v100, v100, v100 row_ror:4 row_mask:0xf bank_mask:0xf
    s_nop 1
    v_max_f32_dpp v100, v100, v100 row_ror:8 row_mask:0xf bank_mask:0xf
    v_mov_b32 v101, v100
    s_nop 1
    v_permlane16_swap_b32 v100, v101
    v_max_f32 v100, v100, v101
    v_mov_b32 v101, v100
    s_nop 1
    v_permlane32_swap_b32 v100, v101
    v_max_f32 v100, v100, v101
    s_mov_b64 exec, 15
    ds_write_b32 v10, v100
    s_mov_b64 exec, -1
    s_waitcnt vmcnt(4)
    buffer_load_dwordx4 v13, s[32:35], s39 offen offset:1024 nt lds
    s_waitcnt lgkmcnt(0)
    s_barrier
    ds_read_b128 v[96:99], v9
    ds_read_b128 v[100:103], v9 offset:16
    s_waitcnt lgkmcnt(0)
    v_max3_f32 v96, v96, v97, v98
    v_max3_f32 v99, v99, v100, v101
    v_max3_f32 v96, v96, v102, v103
    v_max_f32 v96, v96, v99
    v_mul_f32 v96, s44, v96
    v_fma_f32 v104, v104, s44, -v96
    v_fma_f32 v105, v105, s44, -v96
    v_fma_f32 v106, v106, s44, -v96
    v_fma_f32 v107, v107, s44, -v96
    v_exp_f32 v104, v104
    v_exp_f32 v105, v105
    v_exp_f32 v106, v106
    v_exp_f32 v107, v107
    v_cvt_pk_bf16_f32 v100, v104, v105
    v_cvt_pk_bf16_f32 v101, v106, v107
    v_add_f32 v104, v104, v105
    v_add_f32 v106, v106, v107
    ds_write_b16 v84, v100
    ds_write_b16_d16_hi v84, v100 offset:256
    ds_write_b16 v84, v101 offset:512
    ds_write_b16_d16_hi v84, v101 offset:768
    v_add_f32 v104, v104, v106
    s_nop 1
    v_add_f32_dpp v104, v104, v104 row_ror:4 row_mask:0xf bank_mask:0xf
    s_nop 1
    v_add_f32_dpp v104, v104, v104 row_ror:8 row_mask:0xf bank_mask:0xf
    v_mov_b32 v105, v104
    s_nop 1
    v_permlane16_swap_b32 v104, v105
    v_add_f32 v104, v104, v105
    v_mov_b32 v105, v104
    s_nop 1
    v_permlane32_swap_b32 v104, v105
    v_add_f32 v104, v104, v105
    s_mov_b64 exec, 15
    ds_write_b32 v10, v104 offset:128
    s_mov_b64 exec, -1
    s_waitcnt vmcnt(4)
    buffer_load_dwordx4 v14, s[32:35], s39 offen offset:2048 nt lds
    s_waitcnt vmcnt(4)
    buffer_load_dwordx4 v15, s[32:35], s39 offen offset:3072 nt lds
    s_waitcnt vmcnt(4) lgkmcnt(0)
    s_barrier
    ds_read_b64_tr_b16 v[16:17], v85 offset:0
    ds_read_b64_tr_b16 v[18:19], v85 offset:16384
    ds_read_b64_tr_b16 v[24:25], v85 offset:32768
    ds_read_b64_tr_b16 v[26:27], v85 offset:49152
    ds_read_b64_tr_b16 v[32:33], v86 offset:0
    ds_read_b64_tr_b16 v[34:35], v86 offset:16384
    ds_read_b64_tr_b16 v[40:41], v86 offset:32768
    ds_read_b64_tr_b16 v[42:43], v86 offset:49152
    ds_read_b128 v[20:23], v11 offset:0
    ds_read_b128 v[28:31], v11 offset:64
    ds_read_b128 v[36:39], v11 offset:128
    ds_read_b128 v[44:47], v11 offset:192
    ds_read_b64_tr_b16 v[48:49], v85 offset:4096
    ds_read_b64_tr_b16 v[50:51], v85 offset:20480
    ds_read_b64_tr_b16 v[56:57], v85 offset:36864
    ds_read_b64_tr_b16 v[58:59], v85 offset:53248
    ds_read_b64_tr_b16 v[64:65], v86 offset:4096
    ds_read_b64_tr_b16 v[66:67], v86 offset:20480
    ds_read_b64_tr_b16 v[72:73], v86 offset:36864
    ds_read_b64_tr_b16 v[74:75], v86 offset:53248
    ds_read_b128 v[52:55], v11 offset:256
    ds_read_b128 v[60:63], v11 offset:320
    ds_read_b128 v[68:71], v11 offset:384
    ds_read_b128 v[76:79], v11 offset:448
    s_waitcnt lgkmcnt(12)
    v_mfma_f32_16x16x32_bf16 v[90:93], v[16:19], v[20:23], 0
    v_mfma_f32_16x16x32_bf16 v[90:93], v[24:27], v[28:31], v[90:93]
    v_mfma_f32_16x16x32_bf16 v[90:93], v[32:35], v[36:39], v[90:93]
    v_mfma_f32_16x16x32_bf16 v[90:93], v[40:43], v[44:47], v[90:93]
    ds_read_b64_tr_b16 v[16:17], v85 offset:8192
    ds_read_b64_tr_b16 v[18:19], v85 offset:24576
    ds_read_b64_tr_b16 v[24:25], v85 offset:40960
    ds_read_b64_tr_b16 v[26:27], v85 offset:57344
    ds_read_b64_tr_b16 v[32:33], v86 offset:8192
    ds_read_b64_tr_b16 v[34:35], v86 offset:24576
    ds_read_b64_tr_b16 v[40:41], v86 offset:40960
    ds_read_b64_tr_b16 v[42:43], v86 offset:57344
    ds_read_b128 v[20:23], v11 offset:512
    ds_read_b128 v[28:31], v11 offset:576
    ds_read_b128 v[36:39], v11 offset:640
    ds_read_b128 v[44:47], v11 offset:704
    s_waitcnt lgkmcnt(12)
    v_mfma_f32_16x16x32_bf16 v[90:93], v[48:51], v[52:55], v[90:93]
    v_mfma_f32_16x16x32_bf16 v[90:93], v[56:59], v[60:63], v[90:93]
    v_mfma_f32_16x16x32_bf16 v[90:93], v[64:67], v[68:71], v[90:93]
    v_mfma_f32_16x16x32_bf16 v[90:93], v[72:75], v[76:79], v[90:93]
    ds_read_b128 v[52:55], v11 offset:768
    ds_read_b128 v[60:63], v11 offset:832
    ds_read_b128 v[68:71], v11 offset:896
    ds_read_b128 v[76:79], v11 offset:960
    s_waitcnt lgkmcnt(4)
    v_mfma_f32_16x16x32_bf16 v[90:93], v[16:19], v[20:23], v[90:93]
    v_mfma_f32_16x16x32_bf16 v[90:93], v[24:27], v[28:31], v[90:93]
    v_mfma_f32_16x16x32_bf16 v[90:93], v[32:35], v[36:39], v[90:93]
    v_mfma_f32_16x16x32_bf16 v[90:93], v[40:43], v[44:47], v[90:93]
    s_waitcnt vmcnt(0)
    s_barrier
    ds_read_b64_tr_b16 v[48:49], v85 offset:12288
    ds_read_b64_tr_b16 v[50:51], v85 offset:28672
    ds_read_b64_tr_b16 v[56:57], v85 offset:45056
    ds_read_b64_tr_b16 v[58:59], v85 offset:61440
    ds_read_b64_tr_b16 v[64:65], v86 offset:12288
    ds_read_b64_tr_b16 v[66:67], v86 offset:28672
    ds_read_b64_tr_b16 v[72:73], v86 offset:45056
    ds_read_b64_tr_b16 v[74:75], v86 offset:61440
    s_waitcnt lgkmcnt(6)
    v_mfma_f32_16x16x32_bf16 v[90:93], v[48:51], v[52:55], v[90:93]
    s_waitcnt lgkmcnt(4)
    v_mfma_f32_16x16x32_bf16 v[90:93], v[56:59], v[60:63], v[90:93]
    s_waitcnt lgkmcnt(2)
    v_mfma_f32_16x16x32_bf16 v[90:93], v[64:67], v[68:71], v[90:93]
    s_waitcnt lgkmcnt(0)
    v_mfma_f32_16x16x32_bf16 v[90:93], v[72:75], v[76:79], v[90:93]
    s_mov_b32 exec_lo, 0xff00ff
    s_mov_b32 exec_hi, 0xff00ff
    s_cmp_eq_u32 s45, 1
    s_nop 4
    v_mov_b32_dpp v92, v90 quad_perm:[0,1,2,3] row_mask:0xf bank_mask:0x5
    v_mov_b32_dpp v93, v91 quad_perm:[0,1,2,3] row_mask:0xf bank_mask:0x5
    s_cbranch_scc0 Lf_3
    buffer_store_dwordx4 v[92:95], v87, s[48:51], s40 offen
Lg_4:
    s_mov_b64 exec, -1
    s_cmp_lt_u32 s25, 16
    s_cbranch_scc1 L_lo
    s_mov_b32 s58, 400000
Lp_5:
    buffer_load_dwordx4 v[48:51], v131, s[48:51], s5 offen sc1
    buffer_load_dwordx4 v[16:19], v130, s[48:51], s4 offen offset:0 sc1
    buffer_load_dwordx4 v[20:23], v130, s[48:51], s4 offen offset:128 sc1
    buffer_load_dwordx4 v[24:27], v130, s[48:51], s4 offen offset:256 sc1
    buffer_load_dwordx4 v[28:31], v130, s[48:51], s4 offen offset:384 sc1
    s_waitcnt vmcnt(0)
    v_cmpx_eq_u64 vcc, s[56:57], v[50:51]
    s_cmp_eq_u64 exec, -1
    s_mov_b64 exec, -1
    s_cbranch_scc1 Ld_6
    s_sub_u32 s58, s58, 1
    s_cbranch_scc0 Lp_5
Ld_6:
    v_cmpx_eq_u64 vcc, s[56:57], v[18:19]
    v_cmpx_eq_u64 vcc, s[56:57], v[22:23]
    v_cmpx_eq_u64 vcc, s[56:57], v[26:27]
    v_cmpx_eq_u64 vcc, s[56:57], v[30:31]
    s_cmp_eq_u64 exec, -1
    s_mov_b64 exec, -1
    s_cselect_b32 s41, 1, 0
    s_nop 1
    v_max_f32_dpp v52, v48, v48 row_ror:8 row_mask:0xf bank_mask:0xf
    v_mov_b32 v53, v52
    s_nop 1
    v_permlane16_swap_b32 v52, v53
    v_max_f32 v52, v52, v53
    v_mov_b32 v53, v52
    s_nop 1
    v_permlane32_swap_b32 v52, v53
    v_max_f32 v52, v52, v53
    v_sub_f32 v52, v48, v52
    v_mul_f32 v52, s44, v52
    v_exp_f32 v52, v52
    s_nop 0
    v_mul_f32 v49, v49, v52
    s_nop 1
    v_add_f32_dpp v49, v49, v49 row_ror:8 row_mask:0xf bank_mask:0xf
    v_mov_b32 v53, v49
    s_nop 1
    v_permlane16_swap_b32 v49, v53
    v_add_f32 v49, v49, v53
    v_mov_b32 v53, v49
    s_nop 1
    v_permlane32_swap_b32 v49, v53
    v_add_f32 v49, v49, v53
    v_rcp_f32 v49, v49
    s_nop 0
    v_mul_f32 v52, v52, v49
    v_mov_b32 v53, v52
    s_cmp_eq_u32 s41, 1
    s_cbranch_scc1 L_e1
    s_mov_b32 s58, 400000
Lp_7:
    buffer_load_dwordx4 v[16:19], v130, s[48:51], s4 offen offset:0 sc1
    buffer_load_dwordx4 v[20:23], v130, s[48:51], s4 offen offset:128 sc1
    buffer_load_dwordx4 v[24:27], v130, s[48:51], s4 offen offset:256 sc1
    buffer_load_dwordx4 v[28:31], v130, s[48:51], s4 offen offset:384 sc1
    s_waitcnt vmcnt(0)
    v_cmpx_eq_u64 vcc, s[56:57], v[18:19]
    v_cmpx_eq_u64 vcc, s[56:57], v[22:23]
    v_cmpx_eq_u64 vcc, s[56:57], v[26:27]
    v_cmpx_eq_u64 vcc, s[56:57], v[30:31]
    s_cmp_eq_u64 exec, -1
    s_mov_b64 exec, -1
    s_cbranch_scc1 Ld_8
    s_sub_u32 s58, s58, 1
    s_cbranch_scc0 Lp_7
Ld_8:
L_e1:
    v_pk_mul_f32 v[56:57], v[16:17], v[52:53]
    v_pk_mul_f32 v[58:59], v[20:21], v[52:53]
    v_pk_mul_f32 v[60:61], v[24:25], v[52:53]
    v_pk_mul_f32 v[62:63], v[28:29], v[52:53]
    s_nop 0
    v_permlane32_swap_b32 v56, v60
    v_permlane32_swap_b32 v57, v61
    v_permlane32_swap_b32 v58, v62
    v_permlane32_swap_b32 v59, v63
    v_pk_add_f32 v[56:57], v[56:57], v[60:61]
    v_pk_add_f32 v[58:59], v[58:59], v[62:63]
    s_nop 1
    v_permlane16_swap_b32 v56, v58
    v_permlane16_swap_b32 v57, v59
    v_pk_add_f32 v[56:57], v[56:57], v[58:59]
    s_nop 1
    v_add_f32_dpp v56, v56, v56 row_ror:8 row_mask:0xf bank_mask:0xf
    v_add_f32_dpp v57, v57, v57 row_ror:8 row_mask:0xf bank_mask:0xf
    v_cvt_pk_bf16_f32 v56, v56, v57
    ds_write_b32 v132, v56
    s_mov_b64 exec, s[8:9]
    s_cbranch_execz L_nh
    buffer_store_dwordx4 v[108:111], v135, s[48:51], s7 offen sc1
L_nh:
    s_mov_b64 exec, -1
    s_waitcnt lgkmcnt(0)
    s_barrier
    ds_read_b128 v[64:67], v133 offset:0
    ds_read_b128 v[68:71], v133 offset:64
    ds_read_b128 v[72:75], v133 offset:128
    ds_read_b128 v[76:79], v133 offset:192
    s_waitcnt lgkmcnt(3)
    v_mfma_f32_16x16x32_bf16 v[90:93], v[112:115], v[64:67], 0
    s_waitcnt lgkmcnt(2)
    v_mfma_f32_16x16x32_bf16 v[90:93], v[116:119], v[68:71], v[90:93]
    s_waitcnt lgkmcnt(1)
    v_mfma_f32_16x16x32_bf16 v[90:93], v[120:123], v[72:75], v[90:93]
    s_waitcnt lgkmcnt(0)
    v_mfma_f32_16x16x32_bf16 v[90:93], v[124:127], v[76:79], v[90:93]
    s_mov_b32 exec_lo, 0xff00ff
    s_mov_b32 exec_hi, 0xff00ff
    s_nop 5
    v_mov_b32_dpp v92, v90 quad_perm:[0,1,2,3] row_mask:0xf bank_mask:0x5
    v_mov_b32_dpp v93, v91 quad_perm:[0,1,2,3] row_mask:0xf bank_mask:0x5
    buffer_store_dwordx4 v[92:95], v140, s[48:51], s6 offen sc1
    s_endpgm
L_lo:
    s_cmp_lt_u32 s25, 14
    s_cbranch_scc0 L_end
    s_barrier
    s_add_u32 m0, s96, 0
    s_add_u32 s98, s46, 113664
    buffer_load_dwordx4 v128, s[60:63], s46 offen nt lds
    buffer_load_dwordx4 v128, s[60:63], s98 offen offset:1024 nt lds
    s_add_u32 m0, s96, 16384
    s_add_u32 s98, s47, 7168
    buffer_load_dwordx4 v129, s[52:55], s47 offen nt lds
    buffer_load_dwordx4 v129, s[52:55], s98 offen offset:1024 nt lds
    v_mov_b32 v16, s59
    v_mov_b32 v17, s59
    s_waitcnt vmcnt(2)
    ds_read_b64_tr_b16 v[112:113], v130 offset:0
    ds_read_b64_tr_b16 v[114:115], v130 offset:512
    ds_read_b64_tr_b16 v[116:117], v130 offset:1024
    ds_read_b64_tr_b16 v[118:119], v130 offset:1536
    s_waitcnt lgkmcnt(3)
    v_mfma_f32_16x16x16_bf16 v[24:27], v[112:113], v[16:17], 0
    s_waitcnt lgkmcnt(2)
    v_mfma_f32_16x16x16_bf16 v[24:27], v[114:115], v[16:17], v[24:27]
    s_waitcnt lgkmcnt(1)
    v_mfma_f32_16x16x16_bf16 v[24:27], v[116:117], v[16:17], v[24:27]
    s_waitcnt lgkmcnt(0)
    v_mfma_f32_16x16x16_bf16 v[24:27], v[118:119], v[16:17], v[24:27]
    s_mov_b32 exec_lo, 0xf000f
    s_mov_b32 exec_hi, 0xf000f
    s_nop 5
    ds_write_b128 v138, v[24:27]
    s_mov_b64 exec, -1
    s_waitcnt vmcnt(0)
    ds_read_b64_tr_b16 v[120:121], v131
    ds_read_b64_tr_b16 v[122:123], v132
    ds_read_b64_tr_b16 v[124:125], v133
    ds_read_b64_tr_b16 v[126:127], v134
    s_waitcnt lgkmcnt(0)
    s_barrier
    ds_read_b128 v[96:99], v139
    ds_read_b128 v[100:103], v139 offset:256
    s_waitcnt lgkmcnt(0)
    v_pk_add_f32 v[96:97], v[96:97], v[100:101]
    v_pk_add_f32 v[98:99], v[98:99], v[102:103]
    s_nop 0
    v_add_f32_dpp v96, v96, v96 row_ror:4 row_mask:0xf bank_mask:0xf
    v_add_f32_dpp v97, v97, v97 row_ror:4 row_mask:0xf bank_mask:0xf
    v_add_f32_dpp v98, v98, v98 row_ror:4 row_mask:0xf bank_mask:0xf
    v_add_f32_dpp v99, v99, v99 row_ror:4 row_mask:0xf bank_mask:0xf
    v_add_f32_dpp v96, v96, v96 row_ror:8 row_mask:0xf bank_mask:0xf
    v_add_f32_dpp v97, v97, v97 row_ror:8 row_mask:0xf bank_mask:0xf
    v_add_f32_dpp v98, v98, v98 row_ror:8 row_mask:0xf bank_mask:0xf
    v_add_f32_dpp v99, v99, v99 row_ror:8 row_mask:0xf bank_mask:0xf
    s_mov_b32 s58, 400000
Lp_9:
    buffer_load_dwordx4 v[16:19], v135, s[48:51], s4 offen sc1
    s_waitcnt vmcnt(0)
    v_cmpx_eq_u64 vcc, s[56:57], v[18:19]
    s_cmp_eq_u64 exec, -1
    s_mov_b64 exec, -1
    s_cbranch_scc1 Ld_10
    s_sub_u32 s58, s58, 1
    s_cbranch_scc0 Lp_9
Ld_10:
    v_pk_mov_b32 v[44:45], v[16:17], v[16:17] op_sel:[0,1]
    s_nop 1
    v_mfma_f32_16x16x16_bf16 v[24:27], v[112:113], v[44:45], 0
    v_mfma_f32_16x16x16_bf16 v[28:31], v[114:115], v[44:45], 0
    v_mfma_f32_16x16x16_bf16 v[32:35], v[116:117], v[44:45], 0
    v_mfma_f32_16x16x16_bf16 v[36:39], v[118:119], v[44:45], 0
    v_dot2_f32_bf16 v40, v44, s59, 0
    v_dot2_f32_bf16 v41, v44, v44, 0
    v_dot2_f32_bf16 v40, v45, s59, v40
    v_dot2_f32_bf16 v41, v45, v45, v41
    s_nop 1
    v_add_f32_dpp v40, v40, v40 row_ror:4 row_mask:0xf bank_mask:0xf
    v_add_f32_dpp v41, v41, v41 row_ror:4 row_mask:0xf bank_mask:0xf
    s_nop 0
    v_add_f32_dpp v40, v40, v40 row_ror:8 row_mask:0xf bank_mask:0xf
    v_add_f32_dpp v41, v41, v41 row_ror:8 row_mask:0xf bank_mask:0xf
    s_nop 1
    v_permlane16_swap_b32 v40, v41
    v_add_f32 v40, v40, v41
    v_mov_b32 v42, v40
    s_nop 1
    v_permlane32_swap_b32 v40, v42
    v_add_f32 v40, v40, v42
    s_mov_b64 exec, 0x000f000f
    ds_write_b32 v137, v40
    s_mov_b64 exec, -1
    v_add_f32_dpp v24, v28, v24 row_shl:4 row_mask:0xf bank_mask:0xf
    v_add_f32_dpp v25, v29, v25 row_shl:4 row_mask:0xf bank_mask:0xf
    v_add_f32_dpp v26, v30, v26 row_shl:4 row_mask:0xf bank_mask:0xf
    v_add_f32_dpp v27, v31, v27 row_shl:4 row_mask:0xf bank_mask:0xf
    v_add_f32_dpp v24, v32, v24 row_shl:8 row_mask:0xf bank_mask:0xf
    v_add_f32_dpp v25, v33, v25 row_shl:8 row_mask:0xf bank_mask:0xf
    v_add_f32_dpp v26, v34, v26 row_shl:8 row_mask:0xf bank_mask:0xf
    v_add_f32_dpp v27, v35, v27 row_shl:8 row_mask:0xf bank_mask:0xf
    v_add_f32_dpp v24, v36, v24 row_shl:12 row_mask:0xf bank_mask:0xf
    v_add_f32_dpp v25, v37, v25 row_shl:12 row_mask:0xf bank_mask:0xf
    v_add_f32_dpp v26, v38, v26 row_shl:12 row_mask:0xf bank_mask:0xf
    v_add_f32_dpp v27, v39, v27 row_shl:12 row_mask:0xf bank_mask:0xf
    s_mov_b32 exec_lo, 0xf000f
    s_mov_b32 exec_hi, 0xf000f
    ds_write_b128 v138, v[24:27] offset:2048
    s_mov_b64 exec, -1
    s_waitcnt lgkmcnt(0)
    s_barrier
    ds_read_b128 v[40:43], v136
    ds_read_b128 v[24:27], v139 offset:2048
    ds_read_b128 v[28:31], v139 offset:2304
    s_waitcnt lgkmcnt(2)
    v_pk_add_f32 v[40:41], v[40:41], v[42:43]
    s_nop 1
    v_add_f32_dpp v40, v40, v40 row_ror:4 row_mask:0xf bank_mask:0xf
    v_add_f32_dpp v41, v41, v41 row_ror:4 row_mask:0xf bank_mask:0xf
    s_nop 0
    v_add_f32_dpp v40, v40, v40 row_ror:8 row_mask:0xf bank_mask:0xf
    v_add_f32_dpp v41, v41, v41 row_ror:8 row_mask:0xf bank_mask:0xf
    s_waitcnt lgkmcnt(0)
    v_pk_add_f32 v[24:25], v[24:25], v[28:29]
    v_pk_add_f32 v[26:27], v[26:27], v[30:31]
    v_mul_f32 v40, 0x3b000000, v40
    v_mul_f32 v41, 0x3b000000, v41
    v_add_f32_dpp v24, v24, v24 row_ror:4 row_mask:0xf bank_mask:0xf
    v_add_f32_dpp v25, v25, v25 row_ror:4 row_mask:0xf bank_mask:0xf
    v_add_f32_dpp v26, v26, v26 row_ror:4 row_mask:0xf bank_mask:0xf
    v_add_f32_dpp v27, v27, v27 row_ror:4 row_mask:0xf bank_mask:0xf
    v_fma_f32 v41, -v40, v40, v41
    v_max_f32 v41, 0, v41
    v_cvt_pk_bf16_f32 v41, v41, v41
    v_and_b32 v41, 0xffff0000, v41
    v_add_f32 v41, 0x3727c5ac, v41
    v_cvt_pk_bf16_f32 v41, v41, v41
    v_and_b32 v41, 0xffff0000, v41
    v_sqrt_f32 v41, v41
    v_add_f32_dpp v24, v24, v24 row_ror:8 row_mask:0xf bank_mask:0xf
    v_add_f32_dpp v25, v25, v25 row_ror:8 row_mask:0xf bank_mask:0xf
    v_add_f32_dpp v26, v26, v26 row_ror:8 row_mask:0xf bank_mask:0xf
    v_add_f32_dpp v27, v27, v27 row_ror:8 row_mask:0xf bank_mask:0xf
    v_cvt_pk_bf16_f32 v41, v41, v41
    v_and_b32 v41, 0xffff0000, v41
    v_cvt_pk_bf16_f32 v40, v40, v40
    v_and_b32 v40, 0xffff0000, v40
    v_rcp_f32 v41, v41
    v_fma_f32 v24, -v40, v96, v24
    v_fma_f32 v25, -v40, v97, v25
    v_fma_f32 v26, -v40, v98, v26
    v_fma_f32 v27, -v40, v99, v27
    v_mul_f32 v24, v24, v41
    v_mul_f32 v25, v25, v41
    v_mul_f32 v26, v26, v41
    v_mul_f32 v27, v27, v41
    v_cvt_pk_bf16_f32 v28, v24, v25
    v_cvt_pk_bf16_f32 v29, v26, v27
    v_lshlrev_b32 v24, 16, v28
    v_and_b32 v25, 0xffff0000, v28
    v_lshlrev_b32 v26, 16, v29
    v_and_b32 v27, 0xffff0000, v29
    v_mul_f32 v28, 0xbfb8aa3b, v24
    v_mul_f32 v29, 0xbfb8aa3b, v25
    v_mul_f32 v30, 0xbfb8aa3b, v26
    v_mul_f32 v31, 0xbfb8aa3b, v27
    v_exp_f32 v28, v28
    v_exp_f32 v29, v29
    v_exp_f32 v30, v30
    v_exp_f32 v31, v31
    v_add_f32 v28, 1.0, v28
    v_add_f32 v29, 1.0, v29
    v_add_f32 v30, 1.0, v30
    v_add_f32 v31, 1.0, v31
    v_rcp_f32 v28, v28
    v_rcp_f32 v29, v29
    v_rcp_f32 v30, v30
    v_rcp_f32 v31, v31
    v_mul_f32 v24, v24, v28
    v_mul_f32 v25, v25, v29
    v_mul_f32 v26, v26, v30
    v_mul_f32 v27, v27, v31
    v_cvt_pk_bf16_f32 v32, v24, v25
    v_cvt_pk_bf16_f32 v33, v26, v27
    s_nop 1
    v_mfma_f32_16x16x16_bf16 v[48:51], v[120:121], v[32:33], 0
    v_mfma_f32_16x16x16_bf16 v[52:55], v[122:123], v[32:33], 0
    v_mfma_f32_16x16x16_bf16 v[56:59], v[124:125], v[32:33], 0
    v_mfma_f32_16x16x16_bf16 v[60:63], v[126:127], v[32:33], 0
    s_nop 4
    v_mov_b32 v92, v48
    v_mov_b32 v93, v49
    s_nop 0
    v_mov_b32_dpp v92, v50 quad_perm:[0,1,2,3] row_mask:0xf bank_mask:0x2
    v_mov_b32_dpp v93, v51 quad_perm:[0,1,2,3] row_mask:0xf bank_mask:0x2
    s_nop 0
    v_mov_b32_dpp v92, v52 quad_perm:[0,1,2,3] row_mask:0xf bank_mask:0x4
    v_mov_b32_dpp v93, v53 quad_perm:[0,1,2,3] row_mask:0xf bank_mask:0x4
    s_nop 0
    v_mov_b32_dpp v92, v54 quad_perm:[0,1,2,3] row_mask:0xf bank_mask:0x8
    v_mov_b32_dpp v93, v55 quad_perm:[0,1,2,3] row_mask:0xf bank_mask:0x8
    buffer_store_dwordx4 v[92:95], v140, s[48:51], s5 offen sc1
    v_mov_b32 v108, v56
    v_mov_b32 v109, v57
    s_nop 0
    v_mov_b32_dpp v108, v58 quad_perm:[0,1,2,3] row_mask:0xf bank_mask:0x2
    v_mov_b32_dpp v109, v59 quad_perm:[0,1,2,3] row_mask:0xf bank_mask:0x2
    s_nop 0
    v_mov_b32_dpp v108, v60 quad_perm:[0,1,2,3] row_mask:0xf bank_mask:0x4
    v_mov_b32_dpp v109, v61 quad_perm:[0,1,2,3] row_mask:0xf bank_mask:0x4
    s_nop 0
    v_mov_b32_dpp v108, v62 quad_perm:[0,1,2,3] row_mask:0xf bank_mask:0x8
    v_mov_b32_dpp v109, v63 quad_perm:[0,1,2,3] row_mask:0xf bank_mask:0x8
    buffer_store_dwordx4 v[108:111], v140, s[48:51], s6 offen sc1
    s_mov_b64 exec, s[8:9]
    s_cbranch_execz L_ns
    s_cmp_eq_u32 s45, 1
    s_cbranch_scc0 Lf_11
    buffer_store_dwordx4 v[92:95], off, s[48:51], s7
Lg_12:
L_ns:
    s_mov_b64 exec, -1
L_lx:
    s_endpgm
L_tail:
    s_add_u32 s3, s3, 4
    s_setprio 3
    s_waitcnt lgkmcnt(0)
    s_load_dwordx2 s[56:57], s[22:23], 0
    s_mov_b32 s28, s22
    s_and_b32 s29, s23, 0xffff
    s_mov_b32 s30, 0xc00000
    s_mov_b32 s31, 0x20000
    s_mov_b32 s59, 0x3f803f80
    s_getreg_b32 s17, hwreg(HW_REG_XCC_ID, 0, 4)
    s_lshl_b32 s9, s24, 9
    s_add_u32 s9, s9, 4096
    s_lshl_b32 s62, s25, 4
    s_add_u32 s62, s62, s9
    v_mov_b32 v32, s17
    s_waitcnt lgkmcnt(0)
    s_add_u32 s56, s56, 0x9e3779b9
    s_add_u32 s57, s57, 0x7f4a7c15
    v_mov_b32 v34, s56
    v_mov_b32 v35, s57
    v_mov_b32 v38, s56
    v_mov_b32 v39, s57
    s_cmp_eq_u32 s3, 0
    s_cselect_b32 exec_lo, 1, 0
    s_mov_b32 exec_hi, 0
    s_cbranch_execz L_nx
    buffer_store_dwordx4 v[32:35], off, s[28:31], s62 sc1
L_nx:
    s_mov_b64 exec, -1
    s_cmp_lt_u32 s25, 16
    s_cbranch_scc0 L_qg
    v_and_b32 v8, 1, v3
    v_lshl_add_u32 v8, v8, 2, v5
    v_lshlrev_b32 v8, 1, v8
    v_lshrrev_b32 v9, 1, v4
    s_mul_i32 s58, s3, 4
    v_add_u32 v9, s58, v9
    v_xor_b32 v8, v8, v9
    v_lshlrev_b32 v140, 4, v8
    v_and_b32 v9, 1, v4
    v_lshl_add_u32 v140, v9, 3, v140
    v_and_b32 v8, 1, v3
    v_lshl_add_u32 v8, v8, 3, v5
    v_lshl_add_u32 v140, v8, 8, v140
    v_lshrrev_b32 v8, 1, v3
    v_lshl_add_u32 v140, v8, 14, v140
    v_xor_b32 v141, 32, v140
    v_add_u32 v142, 0x10000, v140
    v_add_u32 v143, 0x10000, v141
    v_lshlrev_b32 v10, 14, v4
    v_lshl_add_u32 v10, v3, 5, v10
    v_and_b32 v8, 1, v5
    v_lshl_add_u32 v10, v8, 4, v10
    v_lshrrev_b32 v8, 1, v5
    v_lshl_add_u32 v10, v8, 7, v10
    s_lshl_b32 s61, s26, 2
    v_add_u32 v24, s61, v5
    v_lshl_add_u32 v24, v24, 2, v3
    v_lshlrev_b32 v24, 4, v24
    v_add_u32 v25, 256, v24
    v_and_b32 v25, 0x3ff, v25
    v_add_u32 v26, 512, v24
    v_and_b32 v26, 0x3ff, v26
    v_add_u32 v27, 768, v24
    v_and_b32 v27, 0x3ff, v27
    v_lshlrev_b32 v8, 10, v4
    v_add_u32 v8, 131072, v8
    v_add_u32 v144, v8, v24
    v_add_u32 v145, v8, v25
    v_add_u32 v146, v8, v26
    v_add_u32 v147, v8, v27
    s_lshl_b32 s60, s24, 4
    s_add_u32 s60, s60, s27
    s_lshl_b32 s60, s60, 2
    s_add_u32 s60, s60, s26
    s_lshl_b32 s60, s60, 2
    s_add_u32 s60, s60, s3
    s_lshl_b32 s60, s60, 8
    s_add_u32 s60, s60, 524288
    s_mov_b32 s58, 400000
Lw_13:
    ds_read_b32 v14, v155 offset:0
    s_waitcnt lgkmcnt(0)
    v_cmp_ne_u32 vcc, 0x200, v14
    s_cbranch_vccz Lx_14
    s_sleep 1
    s_sub_u32 s58, s58, 1
    s_cbranch_scc0 Lw_13
Lx_14:
    ds_read_b128 v[16:19], v144
    ds_read_b128 v[20:23], v145
    ds_read_b128 v[24:27], v146
    ds_read_b128 v[28:31], v147
    s_waitcnt lgkmcnt(0)
    ds_read_b64_tr_b16 v[60:61], v140 offset:12288
    ds_read_b64_tr_b16 v[62:63], v140 offset:13312
    ds_read_b64_tr_b16 v[64:65], v140 offset:45056
    ds_read_b64_tr_b16 v[66:67], v140 offset:46080
    ds_read_b64_tr_b16 v[68:69], v142 offset:12288
    ds_read_b64_tr_b16 v[70:71], v142 offset:13312
    ds_read_b64_tr_b16 v[72:73], v142 offset:45056
    ds_read_b64_tr_b16 v[74:75], v142 offset:46080
    ds_read_b64_tr_b16 v[76:77], v141 offset:12288
    ds_read_b64_tr_b16 v[78:79], v141 offset:13312
    ds_read_b64_tr_b16 v[80:81], v141 offset:45056
    ds_read_b64_tr_b16 v[82:83], v141 offset:46080
    ds_read_b64_tr_b16 v[84:85], v143 offset:12288
    ds_read_b64_tr_b16 v[86:87], v143 offset:13312
    ds_read_b64_tr_b16 v[88:89], v143 offset:45056
    ds_read_b64_tr_b16 v[90:91], v143 offset:46080
    v_dot2_f32_bf16 v12, v16, s59, 0
    v_dot2_f32_bf16 v13, v16, v16, 0
    v_dot2_f32_bf16 v12, v17, s59, v12
    v_dot2_f32_bf16 v13, v17, v17, v13
    v_dot2_f32_bf16 v12, v18, s59, v12
    v_dot2_f32_bf16 v13, v18, v18, v13
    v_dot2_f32_bf16 v12, v19, s59, v12
    v_dot2_f32_bf16 v13, v19, v19, v13
    v_dot2_f32_bf16 v12, v20, s59, v12
    v_dot2_f32_bf16 v13, v20, v20, v13
    v_dot2_f32_bf16 v12, v21, s59, v12
    v_dot2_f32_bf16 v13, v21, v21, v13
    v_dot2_f32_bf16 v12, v22, s59, v12
    v_dot2_f32_bf16 v13, v22, v22, v13
    v_dot2_f32_bf16 v12, v23, s59, v12
    v_dot2_f32_bf16 v13, v23, v23, v13
    v_dot2_f32_bf16 v12, v24, s59, v12
    v_dot2_f32_bf16 v13, v24, v24, v13
    v_dot2_f32_bf16 v12, v25, s59, v12
    v_dot2_f32_bf16 v13, v25, v25, v13
    v_dot2_f32_bf16 v12, v26, s59, v12
    v_dot2_f32_bf16 v13, v26, v26, v13
    v_dot2_f32_bf16 v12, v27, s59, v12
    v_dot2_f32_bf16 v13, v27, v27, v13
    v_dot2_f32_bf16 v12, v28, s59, v12
    v_dot2_f32_bf16 v13, v28, v28, v13
    v_dot2_f32_bf16 v12, v29, s59, v12
    v_dot2_f32_bf16 v13, v29, v29, v13
    v_dot2_f32_bf16 v12, v30, s59, v12
    v_dot2_f32_bf16 v13, v30, v30, v13
    v_dot2_f32_bf16 v12, v31, s59, v12
    v_dot2_f32_bf16 v13, v31, v31, v13
    s_nop 1
    v_add_f32_dpp v12, v12, v12 row_ror:4 row_mask:0xf bank_mask:0xf
    v_add_f32_dpp v13, v13, v13 row_ror:4 row_mask:0xf bank_mask:0xf
    s_nop 0
    v_add_f32_dpp v12, v12, v12 row_ror:8 row_mask:0xf bank_mask:0xf
    v_add_f32_dpp v13, v13, v13 row_ror:8 row_mask:0xf bank_mask:0xf
    s_nop 1
    v_permlane16_swap_b32 v12, v13
    v_add_f32 v12, v12, v13
    v_mov_b32 v14, v12
    s_nop 1
    v_permlane32_swap_b32 v12, v14
    v_add_f32 v12, v12, v14
    v_mov_b32 v13, v12
    s_nop 1
    v_permlane16_swap_b32 v12, v13
    v_mul_f32 v12, 0x3b000000, v12
    v_mul_f32 v13, 0x3b000000, v13
    v_fma_f32 v13, -v12, v12, v13
    v_max_f32 v13, 0, v13
    v_cvt_pk_bf16_f32 v13, v13, v13
    v_and_b32 v13, 0xffff0000, v13
    v_add_f32 v13, 0x3727c5ac, v13
    v_cvt_pk_bf16_f32 v13, v13, v13
    v_and_b32 v13, 0xffff0000, v13
    v_sqrt_f32 v13, v13
    v_cvt_pk_bf16_f32 v12, v12, v12
    v_and_b32 v12, 0xffff0000, v12
    v_lshlrev_b32 v20, 16, v16
    v_and_b32 v21, 0xffff0000, v16
    v_lshlrev_b32 v22, 16, v17
    v_and_b32 v23, 0xffff0000, v17
    v_lshlrev_b32 v24, 16, v18
    v_and_b32 v25, 0xffff0000, v18
    v_lshlrev_b32 v26, 16, v19
    v_and_b32 v27, 0xffff0000, v19
    v_cvt_pk_bf16_f32 v13, v13, v13
    v_and_b32 v13, 0xffff0000, v13
    v_sub_f32 v20, v20, v12
    v_sub_f32 v21, v21, v12
    v_sub_f32 v22, v22, v12
    v_sub_f32 v23, v23, v12
    v_sub_f32 v24, v24, v12
    v_sub_f32 v25, v25, v12
    v_sub_f32 v26, v26, v12
    v_sub_f32 v27, v27, v12
    v_rcp_f32 v13, v13
    v_cvt_pk_bf16_f32 v16, v20, v21
    v_cvt_pk_bf16_f32 v17, v22, v23
    v_cvt_pk_bf16_f32 v18, v24, v25
    v_cvt_pk_bf16_f32 v19, v26, v27
    v_lshlrev_b32 v20, 16, v16
    v_and_b32 v21, 0xffff0000, v16
    v_lshlrev_b32 v22, 16, v17
    v_and_b32 v23, 0xffff0000, v17
    v_lshlrev_b32 v24, 16, v18
    v_and_b32 v25, 0xffff0000, v18
    v_lshlrev_b32 v26, 16, v19
    v_and_b32 v27, 0xffff0000, v19
    v_mul_f32 v20, v20, v13
    v_mul_f32 v21, v21, v13
    v_mul_f32 v22, v22, v13
    v_mul_f32 v23, v23, v13
    v_mul_f32 v24, v24, v13
    v_mul_f32 v25, v25, v13
    v_mul_f32 v26, v26, v13
    v_mul_f32 v27, v27, v13
    v_cvt_pk_bf16_f32 v16, v20, v21
    v_cvt_pk_bf16_f32 v17, v22, v23
    v_cvt_pk_bf16_f32 v18, v24, v25
    v_cvt_pk_bf16_f32 v19, v26, v27
    s_waitcnt lgkmcnt(0)
    s_nop 0
    v_mfma_f32_16x16x32_bf16 v[96:99], v[60:63], v[16:19], 0
    v_mfma_f32_16x16x32_bf16 v[100:103], v[64:67], v[16:19], 0
    v_mfma_f32_16x16x32_bf16 v[104:107], v[68:71], v[16:19], 0
    v_mfma_f32_16x16x32_bf16 v[108:111], v[72:75], v[16:19], 0
    v_mfma_f32_16x16x32_bf16 v[112:115], v[76:79], v[16:19], 0
    v_mfma_f32_16x16x32_bf16 v[116:119], v[80:83], v[16:19], 0
    v_mfma_f32_16x16x32_bf16 v[120:123], v[84:87], v[16:19], 0
    v_mfma_f32_16x16x32_bf16 v[124:127], v[88:91], v[16:19], 0
    s_nop 1
    v_add_f32_dpp v96, v100, v96 row_shl:4 row_mask:0xf bank_mask:0xf
    v_add_f32_dpp v97, v101, v97 row_shl:4 row_mask:0xf bank_mask:0xf
    v_add_f32_dpp v98, v102, v98 row_shl:4 row_mask:0xf bank_mask:0xf
    v_add_f32_dpp v99, v103, v99 row_shl:4 row_mask:0xf bank_mask:0xf
    v_add_f32_dpp v112, v116, v112 row_shl:4 row_mask:0xf bank_mask:0xf
    v_add_f32_dpp v113, v117, v113 row_shl:4 row_mask:0xf bank_mask:0xf
    v_add_f32_dpp v114, v118, v114 row_shl:4 row_mask:0xf bank_mask:0xf
    v_add_f32_dpp v115, v119, v115 row_shl:4 row_mask:0xf bank_mask:0xf
    v_add_f32_dpp v96, v104, v96 row_shl:8 row_mask:0xf bank_mask:0xf
    v_add_f32_dpp v97, v105, v97 row_shl:8 row_mask:0xf bank_mask:0xf
    v_add_f32_dpp v98, v106, v98 row_shl:8 row_mask:0xf bank_mask:0xf
    v_add_f32_dpp v99, v107, v99 row_shl:8 row_mask:0xf bank_mask:0xf
    v_add_f32_dpp v112, v120, v112 row_shl:8 row_mask:0xf bank_mask:0xf
    v_add_f32_dpp v113, v121, v113 row_shl:8 row_mask:0xf bank_mask:0xf
    v_add_f32_dpp v114, v122, v114 row_shl:8 row_mask:0xf bank_mask:0xf
    v_add_f32_dpp v115, v123, v115 row_shl:8 row_mask:0xf bank_mask:0xf
    v_add_f32_dpp v96, v108, v96 row_shl:12 row_mask:0xf bank_mask:0xf
    v_add_f32_dpp v97, v109, v97 row_shl:12 row_mask:0xf bank_mask:0xf
    v_add_f32_dpp v98, v110, v98 row_shl:12 row_mask:0xf bank_mask:0xf
    v_add_f32_dpp v99, v111, v99 row_shl:12 row_mask:0xf bank_mask:0xf
    v_add_f32_dpp v112, v124, v112 row_shl:12 row_mask:0xf bank_mask:0xf
    v_add_f32_dpp v113, v125, v113 row_shl:12 row_mask:0xf bank_mask:0xf
    v_add_f32_dpp v114, v126, v114 row_shl:12 row_mask:0xf bank_mask:0xf
    v_add_f32_dpp v115, v127, v115 row_shl:12 row_mask:0xf bank_mask:0xf
    v_mov_b32 v32, v96
    v_mov_b32 v33, v97
    s_nop 0
    v_mov_b32_dpp v32, v98 row_shr:4 row_mask:0xf bank_mask:0x2
    v_mov_b32_dpp v33, v99 row_shr:4 row_mask:0xf bank_mask:0x2
    s_nop 0
    v_mov_b32_dpp v32, v112 row_shr:8 row_mask:0xf bank_mask:0x4
    v_mov_b32_dpp v33, v113 row_shr:8 row_mask:0xf bank_mask:0x4
    s_nop 0
    v_mov_b32_dpp v32, v114 row_shr:12 row_mask:0xf bank_mask:0x8
    v_mov_b32_dpp v33, v115 row_shr:12 row_mask:0xf bank_mask:0x8
    s_add_u32 s61, s60, 524288
    buffer_store_dwordx4 v[32:35], v10, s[28:31], s61 offen
    buffer_store_dwordx4 v[32:35], v10, s[28:31], s60 offen sc1
    s_mov_b64 exec, -1
L_qg:
    s_lshl_b32 s60, s3, 5
    s_add_u32 s60, s60, 136384
    v_mov_b32 v31, s60
    s_lshl_b32 s18, s24, 2
    s_add_u32 s18, s18, s3
    s_lshl_b32 s18, s18, 2
    s_add_u32 s18, s18, s26
    s_lshl_b32 s60, s18, 12
    s_lshl_b32 s18, s18, 3
    s_add_u32 s18, s18, s27
    s_lshl_b32 s18, s18, 4
    s_add_u32 s18, s18, 2621440
    s_lshl_b32 s60, s24, 2
    s_add_u32 s60, s60, s26
    s_lshl_b32 s60, s60, 2
    s_add_u32 s60, s60, s3
    s_lshl_b32 s60, s60, 12
    s_add_u32 s60, s60, 1048576
    v_and_b32 v8, 31, v2
    v_lshlrev_b32 v8, 4, v8
    s_mov_b32 s58, 400000
L_gw:
    ds_read_b32 v14, v155 offset:4
    s_waitcnt lgkmcnt(0)
    v_cmp_ne_u32 vcc, 1, v14
    s_cbranch_vccz L_gd
    s_sleep 2
    s_sub_u32 s58, s58, 1
    s_cbranch_scc0 L_gw
L_gd:
    s_mov_b32 s58, 400003
L_ql:
    buffer_load_dwordx4 v[60:63], v6, s[28:31], s60 offen offset:0 sc1
    buffer_load_dwordx4 v[64:67], v6, s[28:31], s60 offen offset:1024 sc1
    buffer_load_dwordx4 v[68:71], v6, s[28:31], s60 offen offset:2048 sc1
    buffer_load_dwordx4 v[72:75], v6, s[28:31], s60 offen offset:3072 sc1
    buffer_load_dwordx4 v[76:79], v8, s[28:31], s9 offen sc1
    s_waitcnt vmcnt(0)
    v_cmpx_eq_u64 vcc, s[56:57], v[62:63]
    v_cmpx_eq_u64 vcc, s[56:57], v[66:67]
    v_cmpx_eq_u64 vcc, s[56:57], v[70:71]
    v_cmpx_eq_u64 vcc, s[56:57], v[74:75]
    v_cmpx_eq_u64 vcc, s[56:57], v[78:79]
    s_cmp_eq_u64 exec, -1
    s_mov_b64 exec, -1
    s_cbranch_scc1 L_qf
    s_sleep 4
    s_and_b32 s61, s58, 3
    s_cmp_le_u32 s61, 1
    s_cselect_b32 s61, 1572864, 0
    s_xor_b32 s60, s60, s61
    s_sub_u32 s58, s58, 1
    s_cbranch_scc0 L_ql
L_qf:
    s_mul_i32 s60, s3, 272
    s_add_u32 s60, s60, 135296
    v_pk_add_f32 v[60:61], v[60:61], v[64:65]
    v_pk_add_f32 v[68:69], v[68:69], v[72:73]
    v_pk_add_f32 v[60:61], v[60:61], v[68:69]
    v_cvt_pk_bf16_f32 v60, v60, v61
    v_lshl_add_u32 v8, v2, 2, s60
    ds_write_b32 v8, v60
    v_cmp_ne_u32 vcc, s17, v76
    s_cmp_eq_u64 vcc, 0
    s_cselect_b32 s16, 1, 0
    v_mov_b32 v8, s16
    v_mov_b32 v9, 137984
    ds_write_b32 v9, v8
    s_waitcnt lgkmcnt(0)
    s_barrier
    s_mov_b32 s48, s4
    s_and_b32 s49, s5, 0xffff
    s_mov_b32 s50, 0x1000
    s_mov_b32 s51, 0x20000
    s_mov_b32 s52, s20
    s_and_b32 s53, s21, 0xffff
    s_mov_b32 s54, 0x1000
    s_mov_b32 s55, 0x20000
    s_lshl_b32 s12, s24, 4
    s_add_u32 s12, s12, s25
    s_sub_u32 s12, s12, 16
    v_bfe_u32 v24, v2, 2, 1
    v_lshlrev_b32 v24, 13, v24
    v_lshl_add_u32 v24, v4, 7, v24
    v_bfe_u32 v8, v2, 2, 1
    v_lshrrev_b32 v9, 5, v2
    v_lshl_add_u32 v8, v8, 1, v9
    v_lshlrev_b32 v8, 1, v8
    v_lshl_add_u32 v8, v4, 10, v8
    s_lshl_b32 s42, s12, 3
    s_and_b32 s42, s42, 0x3ff
    buffer_load_ushort v56, v8, s[48:51], s42 offen
    s_lshr_b32 s43, s12, 2
    s_lshl_b32 s43, s43, 3
    s_and_b32 s44, s12, 3
    s_add_u32 s43, s43, s44
    s_lshl_b32 s43, s43, 11
    s_add_u32 s43, s43, 3145728
    s_add_u32 s41, s43, 8192
    s_lshl_b32 s44, s12, 14
    s_add_u32 s44, s44, 8388608
    s_add_u32 s61, s44, 4096
    s_add_u32 s62, s44, 8192
    s_add_u32 s63, s44, 12288
    s_lshr_b32 s45, s12, 6
    s_lshl_b32 s45, s45, 7
    s_and_b32 s46, s12, 63
    s_add_u32 s45, s45, s46
    s_lshl_b32 s45, s45, 7
    s_add_u32 s45, s45, 4194304
    s_lshl_b32 s46, s24, 9
    s_add_u32 s46, s46, 16384
    s_lshl_b32 s47, s24, 8
    s_add_u32 s47, s47, 32768
    v_lshrrev_b32 v57, 3, v2
    v_lshlrev_b32 v57, 15, v57
    v_lshrrev_b32 v58, 5, v2
    v_xor_b32 v58, 1, v58
    v_lshl_add_u32 v57, v58, 13, v57
    v_lshl_add_u32 v57, v4, 4, v57
    v_lshlrev_b32 v58, 10, v4
    v_min_u32 v59, 13, v2
    v_lshlrev_b32 v59, 4, v59
    s_barrier
    ds_read_b128 v[60:63], v31
    ds_read_b128 v[64:67], v31 offset:16
    s_waitcnt lgkmcnt(0)
    v_max3_f32 v36, v60, v61, v62
    v_max3_f32 v37, v63, v64, v65
    v_max3_f32 v36, v36, v66, v67
    v_max_f32 v36, v36, v37
    s_barrier
    ds_read_b128 v[76:79], v31 offset:128
    ds_read_b128 v[80:83], v31 offset:144
    s_waitcnt lgkmcnt(0)
    v_pk_add_f32 v[76:77], v[76:77], v[78:79]
    v_pk_add_f32 v[80:81], v[80:81], v[82:83]
    v_pk_add_f32 v[76:77], v[76:77], v[80:81]
    v_add_f32 v37, v76, v77
    s_mov_b64 exec, 1
    s_cmp_eq_u32 s16, 1
    s_cbranch_scc0 Lf_15
    buffer_store_dwordx4 v[36:39], off, s[28:31], s18
Lg_16:
    s_mov_b64 exec, -1
    s_cmp_eq_u32 s3, 0
    s_cselect_b32 s60, s25, 0
    s_cmp_ge_u32 s60, 16
    s_cbranch_scc1 L_red
    s_endpgm
L_red:
    s_barrier
    s_barrier
    s_mov_b32 s58, 400000
Lp_17:
    buffer_load_dwordx4 v[120:123], v24, s[28:31], s46 offen sc1
    s_waitcnt vmcnt(0)
    v_cmpx_eq_u64 vcc, s[56:57], v[122:123]
    s_cmp_eq_u64 exec, -1
    s_mov_b64 exec, -1
    s_cbranch_scc1 Ld_18
    s_sub_u32 s58, s58, 1
    s_cbranch_scc0 Lp_17
Ld_18:
    v_lshlrev_b32 v56, 16, v56
    s_mov_b32 s58, 400000
Lp_19:
    buffer_load_dwordx4 v[60:63], v6, s[28:31], s43 offen offset:0 sc1
    buffer_load_dwordx4 v[64:67], v6, s[28:31], s43 offen offset:1024 sc1
    buffer_load_dwordx4 v[68:71], v6, s[28:31], s41 offen offset:0 sc1
    buffer_load_dwordx4 v[72:75], v6, s[28:31], s41 offen offset:1024 sc1
    s_waitcnt vmcnt(0)
    v_cmpx_eq_u64 vcc, s[56:57], v[62:63]
    v_cmpx_eq_u64 vcc, s[56:57], v[66:67]
    v_cmpx_eq_u64 vcc, s[56:57], v[70:71]
    v_cmpx_eq_u64 vcc, s[56:57], v[74:75]
    s_cmp_eq_u64 exec, -1
    s_mov_b64 exec, -1
    s_cbranch_scc1 Ld_20
    s_sub_u32 s58, s58, 1
    s_cbranch_scc0 Lp_19
Ld_20:
    v_pk_add_f32 v[60:61], v[60:61], v[64:65]
    v_pk_add_f32 v[68:69], v[68:69], v[72:73]
    v_pk_add_f32 v[60:61], v[60:61], v[68:69]
    s_nop 1
    v_permlane32_swap_b32 v60, v61
    v_add_f32 v60, v60, v61
    v_mov_b32 v61, v60
    s_nop 1
    v_permlane16_swap_b32 v60, v61
    v_add_f32 v60, v60, v61
    s_nop 1
    v_add_f32_dpp v60, v60, v60 row_ror:8 row_mask:0xf bank_mask:0xf
    v_cvt_pk_bf16_f32 v60, v60, v60
    v_and_b32 v60, 0xffff0000, v60
    v_add_f32 v56, v56, v60
    v_cvt_pk_bf16_f32 v56, v56, v56
    v_and_b32 v56, 0xffff0000, v56
    v_mov_b32 v61, v56
    v_mov_b32 v62, v56
    s_nop 1
    v_permlane32_swap_b32 v61, v62
    v_cvt_pk_bf16_f32 v32, v61, v62
    s_nop 1
    v_mov_b32_dpp v33, v32 row_shl:4 row_mask:0xf bank_mask:0xf
    s_mov_b32 exec_lo, 0xf0f0f0f
    s_mov_b32 exec_hi, 0xf0f0f0f
    buffer_store_dwordx4 v[32:35], v57, s[28:31], s45 offen sc1
    s_mov_b64 exec, -1
    s_mov_b32 s58, 400000
Lp_21:
    buffer_load_dwordx4 v[120:123], v59, s[28:31], s47 offen sc1
    s_waitcnt vmcnt(0)
    v_cmpx_eq_u64 vcc, s[56:57], v[122:123]
    s_cmp_eq_u64 exec, -1
    s_mov_b64 exec, -1
    s_cbranch_scc1 Ld_22
    s_sub_u32 s58, s58, 1
    s_cbranch_scc0 Lp_21
Ld_22:
    s_mov_b32 s58, 400000
Lp_23:
    buffer_load_dwordx4 v[60:63], v6, s[28:31], s44 offen offset:0 sc1
    buffer_load_dwordx4 v[64:67], v6, s[28:31], s44 offen offset:1024 sc1
    buffer_load_dwordx4 v[68:71], v6, s[28:31], s44 offen offset:2048 sc1
    buffer_load_dwordx4 v[72:75], v6, s[28:31], s44 offen offset:3072 sc1
    buffer_load_dwordx4 v[76:79], v6, s[28:31], s61 offen offset:0 sc1
    buffer_load_dwordx4 v[80:83], v6, s[28:31], s61 offen offset:1024 sc1
    buffer_load_dwordx4 v[84:87], v6, s[28:31], s61 offen offset:2048 sc1
    buffer_load_dwordx4 v[88:91], v6, s[28:31], s62 offen offset:0 sc1
    buffer_load_dwordx4 v[92:95], v6, s[28:31], s62 offen offset:1024 sc1
    buffer_load_dwordx4 v[96:99], v6, s[28:31], s62 offen offset:2048 sc1
    buffer_load_dwordx4 v[100:103], v6, s[28:31], s62 offen offset:3072 sc1
    buffer_load_dwordx4 v[104:107], v6, s[28:31], s63 offen offset:0 sc1
    buffer_load_dwordx4 v[108:111], v6, s[28:31], s63 offen offset:1024 sc1
    buffer_load_dwordx4 v[112:115], v6, s[28:31], s63 offen offset:2048 sc1
    s_waitcnt vmcnt(0)
    v_cmpx_eq_u64 vcc, s[56:57], v[62:63]
    v_cmpx_eq_u64 vcc, s[56:57], v[66:67]
    v_cmpx_eq_u64 vcc, s[56:57], v[70:71]
    v_cmpx_eq_u64 vcc, s[56:57], v[74:75]
    v_cmpx_eq_u64 vcc, s[56:57], v[78:79]
    v_cmpx_eq_u64 vcc, s[56:57], v[82:83]
    v_cmpx_eq_u64 vcc, s[56:57], v[86:87]
    v_cmpx_eq_u64 vcc, s[56:57], v[90:91]
    v_cmpx_eq_u64 vcc, s[56:57], v[94:95]
    v_cmpx_eq_u64 vcc, s[56:57], v[98:99]
    v_cmpx_eq_u64 vcc, s[56:57], v[102:103]
    v_cmpx_eq_u64 vcc, s[56:57], v[106:107]
    v_cmpx_eq_u64 vcc, s[56:57], v[110:111]
    v_cmpx_eq_u64 vcc, s[56:57], v[114:115]
    s_cmp_eq_u64 exec, -1
    s_mov_b64 exec, -1
    s_cbranch_scc1 Ld_24
    s_sub_u32 s58, s58, 1
    s_cbranch_scc0 Lp_23
Ld_24:
    v_pk_add_f32 v[60:61], v[60:61], v[64:65]
    v_pk_add_f32 v[68:69], v[68:69], v[72:73]
    v_pk_add_f32 v[76:77], v[76:77], v[80:81]
    v_pk_add_f32 v[84:85], v[84:85], v[88:89]
    v_pk_add_f32 v[92:93], v[92:93], v[96:97]
    v_pk_add_f32 v[100:101], v[100:101], v[104:105]
    v_pk_add_f32 v[108:109], v[108:109], v[112:113]
    v_pk_add_f32 v[60:61], v[60:61], v[68:69]
    v_pk_add_f32 v[76:77], v[76:77], v[84:85]
    v_pk_add_f32 v[92:93], v[92:93], v[100:101]
    v_pk_add_f32 v[60:61], v[60:61], v[76:77]
    v_pk_add_f32 v[92:93], v[92:93], v[108:109]
    v_pk_add_f32 v[60:61], v[60:61], v[92:93]
    s_nop 1
    v_permlane32_swap_b32 v60, v61
    v_add_f32 v60, v60, v61
    v_mov_b32 v61, v60
    s_nop 1
    v_permlane16_swap_b32 v60, v61
    v_add_f32 v60, v60, v61
    s_nop 1
    v_add_f32_dpp v60, v60, v60 row_ror:8 row_mask:0xf bank_mask:0xf
    v_cvt_pk_bf16_f32 v60, v60, v60
    v_and_b32 v60, 0xffff0000, v60
    v_add_f32 v56, v56, v60
    v_mov_b32 v61, v56
    v_mov_b32 v62, v56
    s_nop 1
    v_permlane32_swap_b32 v61, v62
    v_cvt_pk_bf16_f32 v48, v61, v62
    s_nop 1
    v_mov_b32_dpp v49, v48 row_shl:4 row_mask:0xf bank_mask:0xf
    s_mov_b64 exec, 15
    buffer_store_dwordx2 v[48:49], v58, s[52:55], s42 offen
    s_cmp_eq_u32 s12, 0
    s_cbranch_scc0 L_end
    s_mov_b64 exec, 1
    buffer_store_dwordx2 v[34:35], off, s[28:31], 0
L_end:
    s_endpgm
Lf_3:
    buffer_store_dwordx4 v[92:95], v87, s[48:51], s40 offen sc1
    s_branch Lg_4
Lf_11:
    buffer_store_dwordx4 v[92:95], off, s[48:51], s7 sc1
    s_branch Lg_12
Lf_15:
    buffer_store_dwordx4 v[36:39], off, s[28:31], s18 sc1
    s_branch Lg_16
L_last:
    s_endpgm

.section .rodata,"a"
.p2align 6
.amdhsa_kernel sequential_preLN__sliding_block_cached__dense_activation_silu__decode_kernel
  .amdhsa_next_free_vgpr 160
  .amdhsa_next_free_sgpr 102
  .amdhsa_accum_offset 160
  .amdhsa_group_segment_fixed_size 0
  .amdhsa_kernarg_size 88
  .amdhsa_user_sgpr_count 2
  .amdhsa_user_sgpr_kernarg_segment_ptr 1
  .amdhsa_system_sgpr_workgroup_id_x 1
.end_amdhsa_kernel
```
